```python
import torch

def _softmax(x, axis=-1):
    return torch.softmax(x, dim=axis)
def _gelu(x):
    return torch.nn.functional.gelu(x, approximate="tanh")
def _silu(x):
    return torch.nn.functional.silu(x)
def _sigmoid(x):
    return torch.sigmoid(x)
def _layernorm(x, axis=-1, eps=1e-5):
    m = x.mean(dim=axis, keepdim=True)
    v = x.var(dim=axis, keepdim=True, unbiased=False)
    return (x - m) / torch.sqrt(v + eps)
def _scatter_add(tgt, idx, src, axis=0):
    return tgt.clone().index_add_(axis, idx, src)
def _segment_sum(src, seg, n):
    out = torch.zeros((n,) + src.shape[1:], dtype=src.dtype)
    return out.index_add_(0, seg, src)
def _pad(x, pw):
    flat = tuple(v for pair in reversed(pw) for v in pair)
    return torch.nn.functional.pad(x, flat)

kernel_name = 'concat_heads__gqa_block_cached__gqa_block_cached__decode'

def setup_inputs():

    _w = (lambda a: (lambda t: t.to(torch.bfloat16) if t.is_floating_point() else t)(torch.as_tensor(a)))
    def _A_setup():
        B, Sq, D = 2, 1, 1024
        Hq, Hkv, Sk, Dh = 32, 4, 32768, 128
        assert Hq % Hkv == 0, (Hq, Hkv)
        return {
            "x": _w((lambda *s: torch.randn(*s, dtype=torch.bfloat16) * 0.8)(B, Sq, D)),
            "k_cache": _w((lambda *s: torch.randn(*s, dtype=torch.bfloat16) * 0.8)(B, Hkv, Sk, Dh)),
            "v_cache": _w((lambda *s: torch.randn(*s, dtype=torch.bfloat16) * 0.05)(B, Hkv, Sk, Dh)),
            "wq": _w((lambda *s: torch.randn(*s, dtype=torch.bfloat16) * 0.8)(D, Hq * Dh) * (D ** -0.5)),
            "wo": _w((lambda *s: torch.randn(*s, dtype=torch.bfloat16) * 0.05)(Hq * Dh, D) * ((Hq * Dh) ** -0.5)),
        }
    _A_in = _A_setup()

    def _B_setup():
        B, Sq, D = 2, 1, 1024
        Hq, Hkv, Sk, Dh = 32, 4, 32768, 128
        assert Hq % Hkv == 0, (Hq, Hkv)
        return {
            "x": _w((lambda *s: torch.randn(*s, dtype=torch.bfloat16) * 0.8)(B, Sq, D)),
            "k_cache": _w((lambda *s: torch.randn(*s, dtype=torch.bfloat16) * 0.8)(B, Hkv, Sk, Dh)),
            "v_cache": _w((lambda *s: torch.randn(*s, dtype=torch.bfloat16) * 0.05)(B, Hkv, Sk, Dh)),
            "wq": _w((lambda *s: torch.randn(*s, dtype=torch.bfloat16) * 0.8)(D, Hq * Dh) * (D ** -0.5)),
            "wo": _w((lambda *s: torch.randn(*s, dtype=torch.bfloat16) * 0.05)(Hq * Dh, D) * ((Hq * Dh) ** -0.5)),
        }
    _B_in = _B_setup()

    return {
        "A_x": _A_in["x"],
        "A_k_cache": _A_in["k_cache"],
        "A_v_cache": _A_in["v_cache"],
        "A_wq": _A_in["wq"],
        "A_wo": _A_in["wo"],
        "B_x": _B_in["x"],
        "B_k_cache": _B_in["k_cache"],
        "B_v_cache": _B_in["v_cache"],
        "B_wq": _B_in["wq"],
        "B_wo": _B_in["wo"],
    }

def reference(A_x, A_k_cache, A_v_cache, A_wq, A_wo, B_x, B_k_cache, B_v_cache, B_wq, B_wo):
    def _A_ref(x, k_cache, v_cache, wq, wo):
        B, Sq, D = x.shape
        Hq, Dh = 32, 128
        Hkv = k_cache.shape[1]
        rep = Hq // Hkv
        q = (lambda x, *d: x.permute(*d))((x @ wq).reshape(B, Sq, Hq, Dh), 0, 2, 1, 3)
        k = (lambda x, n, axis: torch.repeat_interleave(x, n, dim=axis))(k_cache, rep, axis=1)
        v = (lambda x, n, axis: torch.repeat_interleave(x, n, dim=axis))(v_cache, rep, axis=1)
        scores = torch.einsum("bhqd,bhkd->bhqk", q, k) * (Dh ** -0.5)
        p = _softmax(scores, axis=-1)
        o = torch.einsum("bhqk,bhkd->bhqd", p, v)
        return (lambda x, *d: x.permute(*d))(o, 0, 2, 1, 3).reshape(B, Sq, Hq * Dh) @ wo

    def _B_ref(x, k_cache, v_cache, wq, wo):
        B, Sq, D = x.shape
        Hq, Dh = 32, 128
        Hkv = k_cache.shape[1]
        rep = Hq // Hkv
        q = (lambda x, *d: x.permute(*d))((x @ wq).reshape(B, Sq, Hq, Dh), 0, 2, 1, 3)
        k = (lambda x, n, axis: torch.repeat_interleave(x, n, dim=axis))(k_cache, rep, axis=1)
        v = (lambda x, n, axis: torch.repeat_interleave(x, n, dim=axis))(v_cache, rep, axis=1)
        scores = torch.einsum("bhqd,bhkd->bhqk", q, k) * (Dh ** -0.5)
        p = _softmax(scores, axis=-1)
        o = torch.einsum("bhqk,bhkd->bhqd", p, v)
        return (lambda x, *d: x.permute(*d))(o, 0, 2, 1, 3).reshape(B, Sq, Hq * Dh) @ wo

    a = _A_ref(A_x, A_k_cache, A_v_cache, A_wq, A_wo)
    b = _B_ref(B_x, B_k_cache, B_v_cache, B_wq, B_wo)
    return torch.concatenate([a, b], axis=-1)
```

```asm
; @launch grid=(256,1,1) block=(512,1,1) lds=163840
.amdgcn_target "amdgcn-amd-amdhsa--gfx950"
.text
.globl concat_heads__gqa_block_cached__gqa_block_cached__decode_kernel
.p2align 8
.type concat_heads__gqa_block_cached__gqa_block_cached__decode_kernel,@function
concat_heads__gqa_block_cached__gqa_block_cached__decode_kernel:
    s_cmp_ge_u32 s2, 256
    s_cbranch_scc1 L_end
    s_load_dwordx16 s[16:31], s[0:1], 0
    s_load_dwordx8 s[32:39], s[0:1], 64
    s_load_dwordx2 s[40:41], s[0:1], 96
    v_lshrrev_b32 v1, 6, v0
    v_and_b32 v0, 63, v0
    v_readfirstlane_b32 s3, v1
    v_and_b32 v2, 1, v0
    v_cmp_eq_u32 vcc, 1, v2
    v_mov_b32 v3, 0x7fffffff
    s_nop 0
    v_cndmask_b32 v2, 0, v3, vcc
    v_cmp_gt_u32 vcc, 16, v0
    v_lshlrev_b32 v3, 2, v0
    v_add_u32 v3, 131072, v3
    v_cndmask_b32 v2, 0, v2, vcc
    ds_write_b32 v3, v2
    s_lshr_b32 s10, s2, 4
    s_and_b32 s9, s2, 15
    s_lshr_b32 s6, s10, 3
    s_bfe_u32 s7, s10, 0x10002
    s_and_b32 s8, s10, 3
    s_and_b32 s82, s10, 7
    s_lshl_b32 s11, s82, 4
    s_add_u32 s11, s11, s9
    s_and_b32 s12, s11, 1
    s_lshr_b32 s13, s11, 1
    s_and_b32 s14, s11, 7
    s_lshl_b32 s14, s14, 2
    s_lshr_b32 s15, s11, 5
    s_add_u32 s14, s14, s15
    s_bfe_u32 s15, s11, 0x20003
    s_xor_b32 s3, s3, 4
    s_and_b32 s76, s3, 3
    s_lshl_b32 s77, s76, 15
    s_mov_b32 s83, 0x100000
    s_mov_b32 s84, 0x3e0293ee
    s_mov_b32 s47, 0x00020000
    s_mov_b32 s51, 0x00020000
    s_mov_b32 s55, 0x00020000
    s_mov_b32 s59, 0x00020000
    s_mov_b32 s63, 0x00020000
    s_mov_b32 s67, 0x00020000
    s_mov_b32 s71, 0x00020000
    s_mov_b32 s75, 0x00020000
    s_mov_b32 s46, 0x800000
    s_mov_b32 s50, 0x800000
    s_mov_b32 s62, 4096
    s_mov_b32 s66, 0x400000
    s_mov_b32 s70, 256
    s_mov_b32 s74, 8192
    s_lshl_b32 s82, s82, 23
    s_lshl_b32 s5, s12, 2
    s_add_u32 s5, s5, s76
    s_lshl_b32 s86, s5, 20
    s_lshl_b32 s87, s13, 7
    s_add_u32 s86, s86, s87
    s_sub_u32 s54, 0x800000, s86
    s_lshl_b32 s87, s76, 7
    s_lshl_b32 s79, s14, 18
    s_add_u32 s79, s79, s87
    s_lshl_b32 s87, s15, 9
    s_add_u32 s79, s79, s87
    s_sub_u32 s58, 0x800000, s79
    s_mov_b32 s87, s79
    v_and_b32 v8, 7, v0
    v_bfe_u32 v9, v0, 4, 1
    v_lshlrev_b32 v9, 1, v9
    v_xor_b32 v8, v8, v9
    v_lshlrev_b32 v8, 4, v8
    v_lshrrev_b32 v9, 3, v0
    v_lshl_add_u32 v3, v9, 13, v8
    v_xor_b32 v4, 64, v3
    s_mov_b32 m0, s77
    s_mov_b32 s79, 0
    s_cmp_eq_u32 s6, 0
    s_waitcnt lgkmcnt(0)
    s_cselect_b64 s[22:23], s[22:23], s[32:33]
    s_add_u32 s52, s22, s86
    s_addc_u32 s53, s23, 0
    s_cmp_lt_u32 s3, 4
    s_cbranch_scc1 L_consumer
L_loader:
    s_setprio 3
    buffer_load_dwordx4 v3, s[52:55], s79 offen nt lds
    s_add_u32 m0, m0, 1024
    s_add_u32 s79, s79, 65536
    buffer_load_dwordx4 v4, s[52:55], s79 offen nt lds
    s_add_u32 m0, m0, 1024
    s_add_u32 s79, s79, 65536
    buffer_load_dwordx4 v3, s[52:55], s79 offen nt lds
    s_add_u32 m0, m0, 1024
    s_add_u32 s79, s79, 65536
    buffer_load_dwordx4 v4, s[52:55], s79 offen nt lds
    s_add_u32 m0, m0, 1024
    s_add_u32 s79, s79, 65536
    buffer_load_dwordx4 v3, s[52:55], s79 offen nt lds
    s_add_u32 m0, m0, 1024
    s_add_u32 s79, s79, 65536
    buffer_load_dwordx4 v4, s[52:55], s79 offen nt lds
    s_add_u32 m0, m0, 1024
    s_add_u32 s79, s79, 65536
    buffer_load_dwordx4 v3, s[52:55], s79 offen nt lds
    s_add_u32 m0, m0, 1024
    s_add_u32 s79, s79, 65536
    buffer_load_dwordx4 v4, s[52:55], s79 offen nt lds
    s_add_u32 m0, m0, 1024
    s_add_u32 s79, s79, 65536
    buffer_load_dwordx4 v3, s[52:55], s79 offen nt lds
    s_add_u32 m0, m0, 1024
    s_add_u32 s79, s79, 65536
    buffer_load_dwordx4 v4, s[52:55], s79 offen nt lds
    s_add_u32 m0, m0, 1024
    s_add_u32 s79, s79, 65536
    buffer_load_dwordx4 v3, s[52:55], s79 offen nt lds
    s_add_u32 m0, m0, 1024
    s_add_u32 s79, s79, 65536
    buffer_load_dwordx4 v4, s[52:55], s79 offen nt lds
    s_add_u32 m0, m0, 1024
    s_add_u32 s79, s79, 65536
    buffer_load_dwordx4 v3, s[52:55], s79 offen nt lds
    s_add_u32 m0, m0, 1024
    s_add_u32 s79, s79, 65536
    buffer_load_dwordx4 v4, s[52:55], s79 offen nt lds
    s_add_u32 m0, m0, 1024
    s_add_u32 s79, s79, 65536
    buffer_load_dwordx4 v3, s[52:55], s79 offen nt lds
    s_add_u32 m0, m0, 1024
    s_add_u32 s79, s79, 65536
    buffer_load_dwordx4 v4, s[52:55], s79 offen nt lds
    s_cmp_eq_u32 s6, 0
    s_cselect_b64 s[18:19], s[18:19], s[28:29]
    s_cselect_b64 s[20:21], s[20:21], s[30:31]
    s_cselect_b64 s[60:61], s[16:17], s[26:27]
    s_cselect_b64 s[24:25], s[24:25], s[34:35]
    s_add_u32 s44, s18, s82
    s_addc_u32 s45, s19, 0
    s_add_u32 s48, s20, s82
    s_addc_u32 s49, s21, 0
    s_add_u32 s56, s24, s87
    s_addc_u32 s57, s25, 0
    s_mov_b64 s[64:65], s[40:41]
    s_mov_b64 s[68:69], s[38:39]
    s_mov_b64 s[72:73], s[36:37]
    s_barrier
    v_mov_b32 v13, 0
    v_lshl_add_u32 v5, v9, 11, v8
    v_xor_b32 v6, 64, v5
    s_lshl_b32 s82, s76, 4
    s_add_u32 s82, s82, 131072
    v_mov_b32 v7, s82
    v_lshrrev_b32 v9, 4, v0
    v_and_b32 v8, 15, v0
    v_lshlrev_b32 v10, 1, v9
    v_xor_b32 v8, v8, v10
    v_lshlrev_b32 v8, 4, v8
    v_lshl_add_u32 v1, v9, 8, v8
    v_xor_b32 v2, 128, v1
    s_mul_i32 s82, s10, 256
    s_add_u32 s82, s82, 0x1000
    v_mov_b32 v11, s82
    s_mov_b32 s42, s82
    s_getpc_b64 s[96:97]
L_pcref:
    s_add_u32 s96, s96, L_waitfree-L_pcref
    s_addc_u32 s97, s97, 0
    s_mov_b32 s80, 8
    s_mov_b32 s81, 0
    s_mov_b32 s85, 0
    s_mov_b32 s43, 0
    s_mov_b32 s38, 4096
    s_mul_i32 s79, s9, 64
    s_and_b32 s79, s9, 7
    s_mul_i32 s79, s79, 128
    s_lshr_b32 s82, s9, 3
    s_lshl_b32 s82, s82, 2
    s_add_u32 s79, s79, s82
    s_add_u32 s79, s79, s76
    s_lshl_b32 s79, s79, 13
    s_add_u32 m0, s77, 24576
    s_mov_b32 s86, 0
    s_waitcnt vmcnt(60)
    buffer_load_dwordx4 v5, s[56:59], s86 offen nt lds
    s_add_u32 m0, m0, 1024
    s_add_u32 s86, s86, 16384
    buffer_load_dwordx4 v6, s[56:59], s86 offen nt lds
    s_add_u32 m0, m0, 1024
    s_add_u32 s86, s86, 16384
    buffer_load_dwordx4 v5, s[56:59], s86 offen nt lds
    s_add_u32 m0, m0, 1024
    s_add_u32 s86, s86, 16384
    buffer_load_dwordx4 v6, s[56:59], s86 offen nt lds
    s_add_u32 m0, m0, 1024
    s_add_u32 s86, s86, 16384
    s_waitcnt vmcnt(60)
    buffer_load_dwordx4 v5, s[56:59], s86 offen nt lds
    s_add_u32 m0, m0, 1024
    s_add_u32 s86, s86, 16384
    buffer_load_dwordx4 v6, s[56:59], s86 offen nt lds
    s_add_u32 m0, m0, 1024
    s_add_u32 s86, s86, 16384
    buffer_load_dwordx4 v5, s[56:59], s86 offen nt lds
    s_add_u32 m0, m0, 1024
    s_add_u32 s86, s86, 16384
    buffer_load_dwordx4 v6, s[56:59], s86 offen nt lds
    s_add_u32 m0, m0, 1024
    s_add_u32 s86, s86, 16384
    s_waitcnt vmcnt(16)
    s_max_i32 s85, s85, 2
    v_mov_b32 v8, s85
    ds_write_b32 v7, v8
    s_waitcnt vmcnt(8)
    s_max_i32 s85, s85, 6
    v_mov_b32 v8, s85
    ds_write_b32 v7, v8
L_lloop:
    s_add_u32 s86, s79, 4096
    s_sub_u32 s82, s80, 7
    s_cmp_ge_i32 s81, s82
    s_cbranch_scc1 L_fok_42
    s_swappc_b64 s[98:99], s[96:97]
L_fok_42:
    s_and_b32 s82, s80, 7
    s_lshl_b32 s82, s82, 12
    s_add_u32 m0, s82, s77
    s_nop 0
    buffer_load_dwordx4 v1, s[44:47], s79 offen offset:0 nt lds
    buffer_load_dwordx4 v2, s[44:47], s79 offen offset:1024 nt lds
    buffer_load_dwordx4 v1, s[44:47], s79 offen offset:2048 nt lds
    buffer_load_dwordx4 v2, s[44:47], s79 offen offset:3072 nt lds
    s_add_u32 s80, s80, 1
    s_waitcnt vmcnt(16)
    s_sub_u32 s82, s80, 4
    s_cmp_lg_u32 s43, 0
    s_cbranch_scc1 L_fin_43
    s_waitcnt vmcnt(4)
    s_sub_u32 s82, s80, 1
L_fin_43:
    s_max_i32 s85, s85, s82
    v_mov_b32 v8, s85
    ds_write_b32 v7, v8
    s_sub_u32 s82, s80, 7
    s_cmp_ge_i32 s81, s82
    s_cbranch_scc1 L_fok_44
    s_swappc_b64 s[98:99], s[96:97]
L_fok_44:
    s_and_b32 s82, s80, 7
    s_lshl_b32 s82, s82, 12
    s_add_u32 m0, s82, s77
    s_nop 0
    buffer_load_dwordx4 v1, s[44:47], s86 offen offset:0 nt lds
    buffer_load_dwordx4 v2, s[44:47], s86 offen offset:1024 nt lds
    buffer_load_dwordx4 v1, s[44:47], s86 offen offset:2048 nt lds
    buffer_load_dwordx4 v2, s[44:47], s86 offen offset:3072 nt lds
    s_add_u32 s80, s80, 1
    s_waitcnt vmcnt(16)
    s_sub_u32 s82, s80, 4
    s_cmp_lg_u32 s43, 0
    s_cbranch_scc1 L_fin_45
    s_waitcnt vmcnt(4)
    s_sub_u32 s82, s80, 1
L_fin_45:
    s_max_i32 s85, s85, s82
    v_mov_b32 v8, s85
    ds_write_b32 v7, v8
    s_sub_u32 s82, s80, 7
    s_cmp_ge_i32 s81, s82
    s_cbranch_scc1 L_fok_46
    s_swappc_b64 s[98:99], s[96:97]
L_fok_46:
    s_and_b32 s82, s80, 7
    s_lshl_b32 s82, s82, 12
    s_add_u32 m0, s82, s77
    s_nop 0
    buffer_load_dwordx4 v1, s[48:51], s79 offen offset:0 nt lds
    buffer_load_dwordx4 v2, s[48:51], s79 offen offset:1024 nt lds
    buffer_load_dwordx4 v1, s[48:51], s79 offen offset:2048 nt lds
    buffer_load_dwordx4 v2, s[48:51], s79 offen offset:3072 nt lds
    s_add_u32 s80, s80, 1
    s_waitcnt vmcnt(16)
    s_sub_u32 s82, s80, 4
    s_cmp_lg_u32 s43, 0
    s_cbranch_scc1 L_fin_47
    s_waitcnt vmcnt(4)
    s_sub_u32 s82, s80, 1
L_fin_47:
    s_max_i32 s85, s85, s82
    v_mov_b32 v8, s85
    ds_write_b32 v7, v8
    s_sub_u32 s82, s80, 7
    s_cmp_ge_i32 s81, s82
    s_cbranch_scc1 L_fok_48
    s_swappc_b64 s[98:99], s[96:97]
L_fok_48:
    s_and_b32 s82, s80, 7
    s_lshl_b32 s82, s82, 12
    s_add_u32 m0, s82, s77
    s_nop 0
    buffer_load_dwordx4 v1, s[48:51], s86 offen offset:0 nt lds
    buffer_load_dwordx4 v2, s[48:51], s86 offen offset:1024 nt lds
    buffer_load_dwordx4 v1, s[48:51], s86 offen offset:2048 nt lds
    buffer_load_dwordx4 v2, s[48:51], s86 offen offset:3072 nt lds
    s_cmp_lt_u32 s80, 63
    s_cbranch_scc1 L_noclaim_49
    s_mov_b32 s95, 1
    s_atomic_add s95, s[40:41], s42 glc
L_noclaim_49:
    s_add_u32 s80, s80, 1
    s_waitcnt vmcnt(16)
    s_sub_u32 s82, s80, 4
    s_cmp_lg_u32 s43, 0
    s_cbranch_scc1 L_fin_50
    s_waitcnt vmcnt(4)
    s_sub_u32 s82, s80, 1
L_fin_50:
    s_max_i32 s85, s85, s82
    v_mov_b32 v8, s85
    ds_write_b32 v7, v8
    s_add_u32 s79, s79, 65536
    s_cmp_le_u32 s80, 60
    s_cbranch_scc1 L_lloop
    s_waitcnt lgkmcnt(0)
    s_mov_b32 s82, s95
    s_cmp_ge_u32 s82, 80
    s_cselect_b32 s43, 1, 0
    s_mul_hi_u32 s86, s82, 268435456
    s_mul_i32 s79, s86, 112
    s_add_u32 s79, s79, s82
    s_add_u32 s79, s79, 112
    s_lshl_b32 s79, s79, 13
    s_cmp_lt_u32 s82, 128
    s_cbranch_scc1 L_lloop
L_ldone:
    s_mov_b32 s93, s80
    v_mov_b32 v8, s80
    ds_write_b32 v7, v8 offset:4
    s_mov_b32 s79, 0
    s_waitcnt vmcnt(12)
    s_sub_u32 s82, s80, 3
    s_max_i32 s85, s85, s82
    v_mov_b32 v8, s85
    ds_write_b32 v7, v8
    s_waitcnt vmcnt(8)
    s_sub_u32 s82, s80, 2
    s_max_i32 s85, s85, s82
    v_mov_b32 v8, s85
    ds_write_b32 v7, v8
    s_waitcnt vmcnt(4)
    s_sub_u32 s82, s80, 1
    s_max_i32 s85, s85, s82
    v_mov_b32 v8, s85
    ds_write_b32 v7, v8
    s_waitcnt vmcnt(0)
    s_sub_u32 s82, s80, 0
    s_max_i32 s85, s85, s82
    v_mov_b32 v8, s85
    ds_write_b32 v7, v8
    s_waitcnt lgkmcnt(0)
    s_barrier
    s_barrier
    s_add_u32 m0, s77, 8192
    s_mov_b32 s79, 131072
    s_nop 0
    buffer_load_dwordx4 v5, s[56:59], s79 offen nt lds
    s_add_u32 m0, m0, 1024
    s_add_u32 s79, s79, 16384
    s_nop 0
    buffer_load_dwordx4 v6, s[56:59], s79 offen nt lds
    s_add_u32 m0, m0, 1024
    s_add_u32 s79, s79, 16384
    s_nop 0
    buffer_load_dwordx4 v5, s[56:59], s79 offen nt lds
    s_add_u32 m0, m0, 1024
    s_add_u32 s79, s79, 16384
    s_nop 0
    buffer_load_dwordx4 v6, s[56:59], s79 offen nt lds
    s_add_u32 m0, m0, 1024
    s_add_u32 s79, s79, 16384
    s_nop 0
    buffer_load_dwordx4 v5, s[56:59], s79 offen nt lds
    s_add_u32 m0, m0, 1024
    s_add_u32 s79, s79, 16384
    s_nop 0
    buffer_load_dwordx4 v6, s[56:59], s79 offen nt lds
    s_add_u32 m0, m0, 1024
    s_add_u32 s79, s79, 16384
    s_nop 0
    buffer_load_dwordx4 v5, s[56:59], s79 offen nt lds
    s_add_u32 m0, m0, 1024
    s_add_u32 s79, s79, 16384
    s_nop 0
    buffer_load_dwordx4 v6, s[56:59], s79 offen nt lds
    s_add_u32 m0, m0, 1024
    s_add_u32 s79, s79, 16384
    s_waitcnt vmcnt(0)
    s_add_u32 s82, s93, 4
    s_max_i32 s85, s85, s82
    v_mov_b32 v8, s85
    ds_write_b32 v7, v8
L_end:
    s_endpgm
L_waitfree:
    ds_read_b32 v9, v7 offset:8
    s_waitcnt lgkmcnt(0)
    v_readfirstlane_b32 s81, v9
    s_cmp_ge_i32 s81, s82
    s_cbranch_scc1 L_wfret_51
    s_waitcnt vmcnt(12)
    s_sub_u32 s87, s80, 3
    s_max_i32 s85, s85, s87
    v_mov_b32 v8, s85
    ds_write_b32 v7, v8
    ds_read_b32 v9, v7 offset:8
    s_waitcnt lgkmcnt(0)
    v_readfirstlane_b32 s81, v9
    s_cmp_ge_i32 s81, s82
    s_cbranch_scc1 L_wfret_51
    s_waitcnt vmcnt(8)
    s_sub_u32 s87, s80, 2
    s_max_i32 s85, s85, s87
    v_mov_b32 v8, s85
    ds_write_b32 v7, v8
    ds_read_b32 v9, v7 offset:8
    s_waitcnt lgkmcnt(0)
    v_readfirstlane_b32 s81, v9
    s_cmp_ge_i32 s81, s82
    s_cbranch_scc1 L_wfret_51
    s_waitcnt vmcnt(4)
    s_sub_u32 s87, s80, 1
    s_max_i32 s85, s85, s87
    v_mov_b32 v8, s85
    ds_write_b32 v7, v8
    ds_read_b32 v9, v7 offset:8
    s_waitcnt lgkmcnt(0)
    v_readfirstlane_b32 s81, v9
    s_cmp_ge_i32 s81, s82
    s_cbranch_scc1 L_wfret_51
    s_waitcnt vmcnt(0)
    s_sub_u32 s87, s80, 0
    s_max_i32 s85, s85, s87
    v_mov_b32 v8, s85
    ds_write_b32 v7, v8
L_wfp_52:
    ds_read_b32 v9, v7 offset:8
    s_waitcnt lgkmcnt(0)
    v_readfirstlane_b32 s81, v9
    s_cmp_ge_i32 s81, s82
    s_cbranch_scc1 L_wfret_51
    s_cmp_eq_u32 s83, 0
    s_cbranch_scc1 L_wfret_51
    s_sub_u32 s83, s83, 1
    s_sleep 1
    s_branch L_wfp_52
L_wfret_51:
    s_setpc_b64 s[98:99]
L_consumer:
    s_cmp_eq_u32 s6, 0
    s_cselect_b64 s[18:19], s[18:19], s[28:29]
    s_cselect_b64 s[20:21], s[20:21], s[30:31]
    s_cselect_b64 s[60:61], s[16:17], s[26:27]
    s_cselect_b64 s[24:25], s[24:25], s[34:35]
    s_add_u32 s44, s18, s82
    s_addc_u32 s45, s19, 0
    s_add_u32 s48, s20, s82
    s_addc_u32 s49, s21, 0
    s_add_u32 s56, s24, s87
    s_addc_u32 s57, s25, 0
    s_mov_b64 s[64:65], s[40:41]
    s_mov_b64 s[68:69], s[38:39]
    s_mov_b64 s[72:73], s[36:37]
    s_lshl_b32 s87, s6, 7
    s_load_dword s90, s[40:41], s87
    v_lshrrev_b32 v1, 4, v0
    v_and_b32 v2, 15, v0
    v_and_b32 v4, 1, v0
    v_lshlrev_b32 v5, 11, v4
    v_lshl_add_u32 v5, v1, 4, v5
    s_lshl_b32 s82, s5, 8
    buffer_load_dwordx4 v[52:55], v5, s[60:63], s82 offen offset:0
    buffer_load_dwordx4 v[56:59], v5, s[60:63], s82 offen offset:64
    buffer_load_dwordx4 v[60:63], v5, s[60:63], s82 offen offset:128
    buffer_load_dwordx4 v[64:67], v5, s[60:63], s82 offen offset:192
    s_and_b32 s82, s13, 15
    s_or_b32 s82, s82, s76
    s_cmp_lg_u32 s82, 0
    s_cbranch_scc1 L_noinit_1
    s_lshl_b32 s82, s6, 3
    s_lshl_b32 s86, s12, 2
    s_add_u32 s82, s82, s86
    s_lshr_b32 s86, s13, 4
    s_add_u32 s82, s82, s86
    s_mul_i32 s82, s82, 256
    s_add_u32 s82, s82, 0x1000
    v_mul_u32_u24 v6, 256, v0
    v_add_u32 v6, s82, v6
    v_mov_b32 v7, 0
    s_mov_b64 exec, 1
    buffer_store_dword v7, v6, s[64:67], 0 offen sc1
    s_mov_b64 exec, -1
L_noinit_1:
    s_lshl_b32 s82, s76, 4
    s_add_u32 s82, s82, 131072
    v_mov_b32 v3, s82
    v_mov_b32 v8, 131136
    s_lshl_b32 s82, s6, 7
    s_add_u32 s82, s82, s13
    s_lshl_b32 s82, s82, 1
    s_add_u32 s82, s82, s12
    s_lshl_b32 s82, s82, 8
    s_add_u32 s82, s82, 0x10000
    v_lshlrev_b32 v9, 15, v1
    v_lshl_add_u32 v9, v2, 4, v9
    v_add_u32 v9, s82, v9
    s_lshl_b32 s82, s6, 7
    s_lshl_b32 s86, s15, 4
    s_add_u32 s82, s82, s86
    s_lshl_b32 s86, s76, 2
    s_add_u32 s82, s82, s86
    s_lshl_b32 s82, s82, 5
    s_add_u32 s82, s82, s14
    s_lshl_b32 s82, s82, 6
    s_add_u32 s82, s82, 0x80000
    v_lshlrev_b32 v12, 17, v4
    v_lshl_add_u32 v12, v1, 4, v12
    v_add_u32 v12, s82, v12
    v_add_u32 v13, 4096, v12
    s_lshl_b32 s82, s10, 3
    s_lshl_b32 s86, s76, 1
    s_add_u32 s82, s82, s86
    s_lshl_b32 s82, s82, 4
    s_add_u32 s82, s82, s9
    v_lshrrev_b32 v6, 5, v0
    v_lshlrev_b32 v6, 4, v6
    v_add_u32 v6, s82, v6
    v_and_b32 v7, 31, v0
    v_lshlrev_b32 v7, 4, v7
    v_lshl_add_u32 v10, v6, 9, v7
    v_add_u32 v10, 0x100000, v10
    v_lshlrev_b32 v11, 4, v6
    v_add_u32 v11, 0x30000, v11
    v_bfe_u32 v6, v0, 1, 1
    v_and_b32 v7, 1, v0
    v_bfe_u32 v4, v0, 2, 2
    v_lshl_add_u32 v4, v1, 3, v4
    v_bfe_u32 v5, v0, 3, 1
    v_bfe_u32 v180, v0, 4, 1
    v_lshl_add_u32 v5, v180, 1, v5
    v_lshlrev_b32 v5, 1, v5
    v_xor_b32 v5, v5, v6
    v_lshlrev_b32 v5, 4, v5
    v_lshl_add_u32 v5, v4, 7, v5
    v_lshl_add_u32 v5, v7, 3, v5
    v_xor_b32 v32, 0, v5
    v_add_u32 v32, s77, v32
    v_xor_b32 v33, 32, v5
    v_add_u32 v33, s77, v33
    v_xor_b32 v34, 64, v5
    v_add_u32 v34, s77, v34
    v_xor_b32 v35, 96, v5
    v_add_u32 v35, s77, v35
    v_and_b32 v4, 7, v2
    v_lshlrev_b32 v4, 1, v4
    v_xor_b32 v4, v4, v1
    v_lshlrev_b32 v4, 4, v4
    v_lshl_add_u32 v4, v2, 8, v4
    v_xor_b32 v20, 0, v4
    v_add_u32 v20, s77, v20
    v_xor_b32 v21, 64, v4
    v_add_u32 v21, s77, v21
    v_xor_b32 v22, 128, v4
    v_add_u32 v22, s77, v22
    v_xor_b32 v23, 192, v4
    v_add_u32 v23, s77, v23
    v_lshrrev_b32 v4, 2, v0
    v_and_b32 v5, 7, v4
    v_lshlrev_b32 v5, 1, v5
    v_xor_b32 v5, v5, v6
    v_lshlrev_b32 v5, 4, v5
    v_lshl_add_u32 v5, v4, 8, v5
    v_lshl_add_u32 v5, v7, 3, v5
    v_xor_b32 v24, 0, v5
    v_add_u32 v24, s77, v24
    v_xor_b32 v25, 32, v5
    v_add_u32 v25, s77, v25
    v_xor_b32 v26, 64, v5
    v_add_u32 v26, s77, v26
    v_xor_b32 v27, 96, v5
    v_add_u32 v27, s77, v27
    v_xor_b32 v28, 128, v5
    v_add_u32 v28, s77, v28
    v_xor_b32 v29, 160, v5
    v_add_u32 v29, s77, v29
    v_xor_b32 v30, 192, v5
    v_add_u32 v30, s77, v30
    v_xor_b32 v31, 224, v5
    v_add_u32 v31, s77, v31
    s_mul_i32 s82, s76, 4224
    s_add_u32 s82, s82, 136192
    v_mul_u32_u24 v224, 528, v2
    v_lshl_add_u32 v224, v1, 4, v224
    v_add_u32 v224, s82, v224
    s_lshl_b32 s82, s76, 6
    s_add_u32 s82, s82, 153088
    v_lshlrev_b32 v225, 3, v2
    v_add_u32 v225, s82, v225
    v_lshrrev_b32 v4, 5, v0
    v_and_b32 v5, 31, v0
    s_lshl_b32 s82, s76, 1
    v_add_u32 v236, s82, v4
    v_mul_u32_u24 v226, 528, v236
    v_lshl_add_u32 v226, v5, 4, v226
    v_add_u32 v226, 136192, v226
    v_lshlrev_b32 v227, 3, v236
    v_add_u32 v227, 153088, v227
    s_lshl_b32 s82, s6, 6
    s_add_u32 s82, s82, s14
    s_lshl_b32 s82, s82, 4
    v_lshlrev_b32 v236, 9, v4
    v_add_u32 v236, s82, v236
    s_lshl_b32 s86, s76, 2
    v_add_u32 v228, s86, v236
    v_lshlrev_b32 v228, 9, v228
    v_lshl_add_u32 v228, v5, 4, v228
    v_add_u32 v228, 0x100000, v228
    v_xor_b32 v229, s86, v2
    v_add_u32 v229, v229, v236
    v_lshlrev_b32 v229, 4, v229
    v_add_u32 v229, 0x30000, v229
    s_lshl_b32 s82, s76, 10
    v_lshlrev_b32 v231, 4, v0
    v_add_u32 v231, 153600, v231
    v_add_u32 v230, s82, v231
    s_lshl_b32 s82, s76, 9
    s_add_u32 s82, s82, 157696
    v_lshlrev_b32 v232, 3, v0
    v_add_u32 v232, s82, v232
    v_lshlrev_b32 v233, 8, v7
    v_lshl_add_u32 v233, v1, 4, v233
    v_add_u32 v233, s82, v233
    s_lshl_b32 s82, s6, 7
    s_add_u32 s82, s82, s11
    s_lshl_b32 s82, s82, 11
    s_add_u32 s82, s82, 0x80000
    v_lshlrev_b32 v234, 6, v2
    v_lshl_add_u32 v234, v1, 4, v234
    v_add_u32 v234, s82, v234
    s_lshr_b32 s82, s11, 6
    s_lshl_b32 s82, s82, 12
    s_lshl_b32 s86, s6, 11
    s_add_u32 s82, s82, s86
    s_and_b32 s86, s11, 63
    s_lshl_b32 s86, s86, 5
    s_add_u32 s82, s82, s86
    v_lshlrev_b32 v235, 3, v1
    v_add_u32 v235, s82, v235
    s_mov_b32 s81, 0
    s_mov_b32 s93, 0x7fffffff
    s_mov_b32 s43, 0x7fffffff
    s_mov_b32 s92, 0xfffffc00
    s_lshl_b32 s82, s76, 9
    s_add_u32 s82, s82, 133632
    v_lshlrev_b32 v176, 8, v7
    v_lshl_add_u32 v176, v1, 4, v176
    v_add_u32 v176, s82, v176
    v_lshlrev_b32 v177, 4, v0
    v_add_u32 v177, 133632, v177
    v_mov_b32 v178, 1
    s_barrier
    s_cmp_ge_i32 s81, 2
    s_cbranch_scc1 L_pfd_3
L_pf_2:
    ds_read_b64 v[4:5], v3
    s_waitcnt lgkmcnt(0)
    v_readfirstlane_b32 s81, v4
    v_readfirstlane_b32 s93, v5
    s_cmp_ge_i32 s81, 2
    s_cbranch_scc1 L_pfd_3
    s_cmp_eq_u32 s83, 0
    s_cbranch_scc1 L_pfd_3
    s_sub_u32 s83, s83, 1
    s_sleep 1
    s_branch L_pf_2
L_pfd_3:
    s_waitcnt vmcnt(0) lgkmcnt(0)
    s_add_u32 s90, s90, 1
    s_and_b32 s91, s90, 0x3ff
    v_mov_b32 v18, s91
    ds_read_b64_tr_b16 v[112:113], v32 offset:0
    ds_read_b64_tr_b16 v[114:115], v32 offset:512
    ds_read_b64_tr_b16 v[116:117], v33 offset:0
    ds_read_b64_tr_b16 v[118:119], v33 offset:512
    ds_read_b64_tr_b16 v[120:121], v34 offset:0
    ds_read_b64_tr_b16 v[122:123], v34 offset:512
    ds_read_b64_tr_b16 v[124:125], v35 offset:0
    ds_read_b64_tr_b16 v[126:127], v35 offset:512
    ds_read_b64_tr_b16 v[128:129], v32 offset:4096
    ds_read_b64_tr_b16 v[130:131], v32 offset:4608
    ds_read_b64_tr_b16 v[132:133], v33 offset:4096
    ds_read_b64_tr_b16 v[134:135], v33 offset:4608
    ds_read_b64_tr_b16 v[136:137], v34 offset:4096
    ds_read_b64_tr_b16 v[138:139], v34 offset:4608
    ds_read_b64_tr_b16 v[140:141], v35 offset:4096
    ds_read_b64_tr_b16 v[142:143], v35 offset:4608
    s_waitcnt lgkmcnt(8)
    v_mfma_f32_16x16x32_bf16 v[80:83], v[112:115], v[52:55], 0
    v_mfma_f32_16x16x32_bf16 v[84:87], v[116:119], v[52:55], 0
    v_mfma_f32_16x16x32_bf16 v[88:91], v[120:123], v[52:55], 0
    v_mfma_f32_16x16x32_bf16 v[92:95], v[124:127], v[52:55], 0
    s_waitcnt lgkmcnt(0)
    v_mfma_f32_16x16x32_bf16 v[80:83], v[128:131], v[56:59], v[80:83]
    v_mfma_f32_16x16x32_bf16 v[84:87], v[132:135], v[56:59], v[84:87]
    v_mfma_f32_16x16x32_bf16 v[88:91], v[136:139], v[56:59], v[88:91]
    v_mfma_f32_16x16x32_bf16 v[92:95], v[140:143], v[56:59], v[92:95]
    v_mov_b32 v6, 2
    ds_write_b32 v3, v6 offset:8
    s_cmp_ge_i32 s81, 4
    s_cbranch_scc1 L_pfd_5
L_pf_4:
    ds_read_b64 v[4:5], v3
    s_waitcnt lgkmcnt(0)
    v_readfirstlane_b32 s81, v4
    v_readfirstlane_b32 s93, v5
    s_cmp_ge_i32 s81, 4
    s_cbranch_scc1 L_pfd_5
    s_cmp_eq_u32 s83, 0
    s_cbranch_scc1 L_pfd_5
    s_sub_u32 s83, s83, 1
    s_sleep 1
    s_branch L_pf_4
L_pfd_5:
    ds_read_b64_tr_b16 v[144:145], v32 offset:8192
    ds_read_b64_tr_b16 v[146:147], v32 offset:8704
    ds_read_b64_tr_b16 v[148:149], v33 offset:8192
    ds_read_b64_tr_b16 v[150:151], v33 offset:8704
    ds_read_b64_tr_b16 v[152:153], v34 offset:8192
    ds_read_b64_tr_b16 v[154:155], v34 offset:8704
    ds_read_b64_tr_b16 v[156:157], v35 offset:8192
    ds_read_b64_tr_b16 v[158:159], v35 offset:8704
    ds_read_b64_tr_b16 v[160:161], v32 offset:12288
    ds_read_b64_tr_b16 v[162:163], v32 offset:12800
    ds_read_b64_tr_b16 v[164:165], v33 offset:12288
    ds_read_b64_tr_b16 v[166:167], v33 offset:12800
    ds_read_b64_tr_b16 v[168:169], v34 offset:12288
    ds_read_b64_tr_b16 v[170:171], v34 offset:12800
    ds_read_b64_tr_b16 v[172:173], v35 offset:12288
    ds_read_b64_tr_b16 v[174:175], v35 offset:12800
    s_waitcnt lgkmcnt(8)
    v_mfma_f32_16x16x32_bf16 v[80:83], v[144:147], v[60:63], v[80:83]
    v_mfma_f32_16x16x32_bf16 v[84:87], v[148:151], v[60:63], v[84:87]
    v_mfma_f32_16x16x32_bf16 v[88:91], v[152:155], v[60:63], v[88:91]
    v_mfma_f32_16x16x32_bf16 v[92:95], v[156:159], v[60:63], v[92:95]
    s_waitcnt lgkmcnt(0)
    v_mfma_f32_16x16x32_bf16 v[80:83], v[160:163], v[64:67], v[80:83]
    v_mfma_f32_16x16x32_bf16 v[84:87], v[164:167], v[64:67], v[84:87]
    v_mfma_f32_16x16x32_bf16 v[88:91], v[168:171], v[64:67], v[88:91]
    v_mfma_f32_16x16x32_bf16 v[92:95], v[172:175], v[64:67], v[92:95]
    v_mov_b32 v6, 4
    ds_write_b32 v3, v6 offset:8
    s_mov_b32 exec_lo, 0x00030003
    s_mov_b32 exec_hi, 0x00030003
    s_nop 4
    ds_write_b128 v176, v[80:83] offset:0
    ds_write_b128 v176, v[84:87] offset:64
    ds_write_b128 v176, v[88:91] offset:128
    ds_write_b128 v176, v[92:95] offset:192
    s_mov_b64 exec, 1
    s_waitcnt lgkmcnt(0)
    ds_add_rtn_u32 v4, v8, v178
    s_waitcnt lgkmcnt(0)
    v_readfirstlane_b32 s82, v4
    s_mov_b64 exec, -1
    s_cmp_lg_u32 s82, 3
    s_cbranch_scc1 L_noqpub_6
    s_mov_b32 exec_hi, 0
    ds_read_b128 v[112:115], v177 offset:0
    ds_read_b128 v[116:119], v177 offset:512
    ds_read_b128 v[120:123], v177 offset:1024
    ds_read_b128 v[124:127], v177 offset:1536
    s_waitcnt lgkmcnt(0)
    v_add_f32 v112, v112, v116
    v_add_f32 v120, v120, v124
    v_add_f32 v113, v113, v117
    v_add_f32 v121, v121, v125
    v_add_f32 v114, v114, v118
    v_add_f32 v122, v122, v126
    v_add_f32 v115, v115, v119
    v_add_f32 v123, v123, v127
    v_add_f32 v112, v112, v120
    v_add_f32 v113, v113, v121
    v_add_f32 v114, v114, v122
    v_add_f32 v115, v115, v123
    v_and_or_b32 v112, v112, s92, v18
    v_and_or_b32 v113, v113, s92, v18
    v_and_or_b32 v114, v114, s92, v18
    v_and_or_b32 v115, v115, s92, v18
    buffer_store_dwordx4 v[112:115], v9, s[64:67], 0 offen sc1
    s_mov_b64 exec, -1
L_noqpub_6:
    s_cmp_ge_i32 s81, 8
    s_cbranch_scc1 L_pfd_8
L_pf_7:
    ds_read_b64 v[4:5], v3
    s_waitcnt lgkmcnt(0)
    v_readfirstlane_b32 s81, v4
    v_readfirstlane_b32 s93, v5
    s_cmp_ge_i32 s81, 8
    s_cbranch_scc1 L_pfd_8
    s_cmp_eq_u32 s83, 0
    s_cbranch_scc1 L_pfd_8
    s_sub_u32 s83, s83, 1
    s_sleep 1
    s_branch L_pf_7
L_pfd_8:
    ds_read_b64_tr_b16 v[192:193], v32 offset:24576
    ds_read_b64_tr_b16 v[194:195], v32 offset:25088
    ds_read_b64_tr_b16 v[196:197], v33 offset:24576
    ds_read_b64_tr_b16 v[198:199], v33 offset:25088
    ds_read_b64_tr_b16 v[200:201], v34 offset:24576
    ds_read_b64_tr_b16 v[202:203], v34 offset:25088
    ds_read_b64_tr_b16 v[204:205], v35 offset:24576
    ds_read_b64_tr_b16 v[206:207], v35 offset:25088
    ds_read_b64_tr_b16 v[208:209], v32 offset:28672
    ds_read_b64_tr_b16 v[210:211], v32 offset:29184
    ds_read_b64_tr_b16 v[212:213], v33 offset:28672
    ds_read_b64_tr_b16 v[214:215], v33 offset:29184
    ds_read_b64_tr_b16 v[216:217], v34 offset:28672
    ds_read_b64_tr_b16 v[218:219], v34 offset:29184
    ds_read_b64_tr_b16 v[220:221], v35 offset:28672
    ds_read_b64_tr_b16 v[222:223], v35 offset:29184
    s_waitcnt lgkmcnt(0)
    s_waitcnt lgkmcnt(0)
    v_mov_b32 v6, 8
    ds_write_b32 v3, v6 offset:8
    s_lshl_b32 s82, s6, 1
    s_add_u32 s82, s82, s7
    s_lshl_b32 s82, s82, 6
    s_lshl_b32 s86, s8, 4
    s_add_u32 s82, s82, s86
    s_lshl_b32 s86, s76, 2
    s_add_u32 s82, s82, s86
    s_lshl_b32 s82, s82, 9
    s_add_u32 s82, s82, 0x10000
    v_lshlrev_b32 v6, 9, v1
    v_lshl_add_u32 v6, v2, 4, v6
    v_add_u32 v6, s82, v6
    v_lshrrev_b32 v4, 5, v0
    s_lshl_b32 s82, s76, 1
    v_add_u32 v4, s82, v4
    v_mul_u32_u24 v4, 272, v4
    v_and_b32 v5, 31, v0
    v_lshl_add_u32 v4, v5, 3, v4
    v_add_u32 v180, 131328, v4
    v_and_b32 v7, 7, v2
    v_mul_u32_u24 v7, 272, v7
    v_lshl_add_u32 v7, v1, 4, v7
    v_add_u32 v7, 131328, v7
    v_mov_b32 v14, 0xff800000
    v_mov_b32 v15, 0
    v_mov_b32 v80, 0
    v_mov_b32 v81, 0
    v_mov_b32 v82, 0
    v_mov_b32 v83, 0
    v_mov_b32 v84, 0
    v_mov_b32 v85, 0
    v_mov_b32 v86, 0
    v_mov_b32 v87, 0
    v_mov_b32 v88, 0
    v_mov_b32 v89, 0
    v_mov_b32 v90, 0
    v_mov_b32 v91, 0
    v_mov_b32 v92, 0
    v_mov_b32 v93, 0
    v_mov_b32 v94, 0
    v_mov_b32 v95, 0
    v_mov_b32 v96, 0
    v_mov_b32 v97, 0
    v_mov_b32 v98, 0
    v_mov_b32 v99, 0
    v_mov_b32 v100, 0
    v_mov_b32 v101, 0
    v_mov_b32 v102, 0
    v_mov_b32 v103, 0
    v_mov_b32 v104, 0
    v_mov_b32 v105, 0
    v_mov_b32 v106, 0
    v_mov_b32 v107, 0
    v_mov_b32 v108, 0
    v_mov_b32 v109, 0
    v_mov_b32 v110, 0
    v_mov_b32 v111, 0
    s_mov_b32 s78, 10
    s_mov_b32 s94, 0
    v_mov_b32 v181, v6
    s_mov_b64 vcc, -1
L_gq_9:
    s_mov_b64 exec, vcc
    buffer_load_dwordx4 v[184:187], v181, s[64:67], 0 offen offset:0 sc1
    buffer_load_dwordx4 v[188:191], v181, s[64:67], 0 offen offset:256 sc1
    s_mov_b64 exec, -1
    s_cmp_lg_u32 s94, 0
    s_cbranch_scc1 L_nopre_11
    ds_read_b32 v4, v3
    s_waitcnt lgkmcnt(0)
    v_readfirstlane_b32 s81, v4
    s_cmp_lt_i32 s81, 12
    s_cbranch_scc1 L_nopre_11
    ds_read_b128 v[112:115], v20 offset:0
    ds_read_b128 v[116:119], v21 offset:0
    ds_read_b128 v[120:123], v22 offset:0
    ds_read_b128 v[124:127], v23 offset:0
    ds_read_b128 v[128:131], v20 offset:4096
    ds_read_b128 v[132:135], v21 offset:4096
    ds_read_b128 v[136:139], v22 offset:4096
    ds_read_b128 v[140:143], v23 offset:4096
    ds_read_b64_tr_b16 v[144:145], v24 offset:8192
    ds_read_b64_tr_b16 v[146:147], v24 offset:12288
    ds_read_b64_tr_b16 v[148:149], v25 offset:8192
    ds_read_b64_tr_b16 v[150:151], v25 offset:12288
    ds_read_b64_tr_b16 v[152:153], v26 offset:8192
    ds_read_b64_tr_b16 v[154:155], v26 offset:12288
    ds_read_b64_tr_b16 v[156:157], v27 offset:8192
    ds_read_b64_tr_b16 v[158:159], v27 offset:12288
    ds_read_b64_tr_b16 v[160:161], v28 offset:8192
    ds_read_b64_tr_b16 v[162:163], v28 offset:12288
    ds_read_b64_tr_b16 v[164:165], v29 offset:8192
    ds_read_b64_tr_b16 v[166:167], v29 offset:12288
    ds_read_b64_tr_b16 v[168:169], v30 offset:8192
    ds_read_b64_tr_b16 v[170:171], v30 offset:12288
    ds_read_b64_tr_b16 v[172:173], v31 offset:8192
    ds_read_b64_tr_b16 v[174:175], v31 offset:12288
    s_waitcnt lgkmcnt(0)
    v_mov_b32 v6, 12
    ds_write_b32 v3, v6 offset:8
    s_mov_b32 s94, 1
L_nopre_11:
    s_waitcnt vmcnt(0)
    v_bitop3_b32 v4, v18, v184, v185 bitop3:0x7e
    v_bitop3_b32 v176, v18, v186, v187 bitop3:0x7e
    v_bitop3_b32 v177, v18, v188, v189 bitop3:0x7e
    v_or3_b32 v4, v4, v176, v177
    v_bitop3_b32 v176, v18, v190, v191 bitop3:0x7e
    v_or_b32 v4, v4, v176
    v_and_b32 v4, 0x3ff, v4
    v_cmp_ne_u32 vcc, 0, v4
    s_cbranch_vccz L_gqd_10
    s_cmp_eq_u32 s83, 0
    s_cbranch_scc1 L_gqd_10
    s_sub_u32 s83, s83, 1
    s_sleep 4
    s_branch L_gq_9
L_gqd_10:
    v_and_b32 v184, s92, v184
    v_and_b32 v185, s92, v185
    v_and_b32 v186, s92, v186
    v_and_b32 v187, s92, v187
    v_and_b32 v188, s92, v188
    v_and_b32 v189, s92, v189
    v_and_b32 v190, s92, v190
    v_and_b32 v191, s92, v191
    v_add_f32 v184, v184, v188
    v_add_f32 v185, v185, v189
    v_add_f32 v186, v186, v190
    v_add_f32 v187, v187, v191
    v_cvt_pk_bf16_f32 v176, v184, v185
    v_cvt_pk_bf16_f32 v177, v186, v187
    ds_write_b64 v180, v[176:177]
    s_waitcnt lgkmcnt(0)
    s_mov_b64 exec, 1
    ds_add_u32 v8, v178 offset:4
    s_mov_b64 exec, -1
L_qs_12:
    ds_read_b32 v4, v8 offset:4
    s_waitcnt lgkmcnt(0)
    v_readfirstlane_b32 s82, v4
    s_cmp_ge_u32 s82, 4
    s_cbranch_scc1 L_qsd_13
    s_cmp_eq_u32 s83, 0
    s_cbranch_scc1 L_qsd_13
    s_sub_u32 s83, s83, 1
    s_branch L_qs_12
L_qsd_13:
    ds_read_b128 v[36:39], v7 offset:0
    ds_read_b128 v[40:43], v7 offset:64
    ds_read_b128 v[44:47], v7 offset:128
    ds_read_b128 v[48:51], v7 offset:192
    v_xor_b32 v52, 1, v18
    v_xor_b32 v53, 1, v18
    v_xor_b32 v54, 1, v18
    v_xor_b32 v55, 1, v18
    v_xor_b32 v56, 1, v18
    v_xor_b32 v57, 1, v18
    v_xor_b32 v58, 1, v18
    v_xor_b32 v59, 1, v18
    v_xor_b32 v60, 1, v18
    v_xor_b32 v61, 1, v18
    v_xor_b32 v62, 1, v18
    v_xor_b32 v63, 1, v18
    v_xor_b32 v64, 1, v18
    v_xor_b32 v65, 1, v18
    v_xor_b32 v66, 1, v18
    v_xor_b32 v67, 1, v18
    s_mov_b64 s[32:33], -1
    s_mov_b64 s[34:35], -1
    s_mov_b64 s[36:37], -1
    s_mov_b64 s[38:39], -1
    s_mov_b64 s[40:41], -1
    s_waitcnt lgkmcnt(0)
L_cloop:
    s_cmp_lg_u32 s94, 0
    s_cbranch_scc1 L_skp_14
    s_cmp_ge_i32 s81, s78
    s_cbranch_scc1 L_pfd_16
    s_cmp_lt_i32 s93, s78
    s_cbranch_scc1 L_cexit
L_pf_15:
    ds_read_b64 v[4:5], v3
    s_waitcnt lgkmcnt(0)
    v_readfirstlane_b32 s81, v4
    v_readfirstlane_b32 s93, v5
    s_cmp_ge_i32 s81, s78
    s_cbranch_scc1 L_pfd_16
    s_cmp_lt_i32 s93, s78
    s_cbranch_scc1 L_cexit
    s_cmp_eq_u32 s83, 0
    s_cbranch_scc1 L_cexit
    s_sub_u32 s83, s83, 1
    s_sleep 1
    s_branch L_pf_15
L_pfd_16:
    ds_read_b128 v[112:115], v20 offset:0
    ds_read_b128 v[116:119], v21 offset:0
    ds_read_b128 v[120:123], v22 offset:0
    ds_read_b128 v[124:127], v23 offset:0
    ds_read_b128 v[128:131], v20 offset:4096
    ds_read_b128 v[132:135], v21 offset:4096
    ds_read_b128 v[136:139], v22 offset:4096
    ds_read_b128 v[140:143], v23 offset:4096
L_skp_14:
    s_waitcnt lgkmcnt(7)
    v_mfma_f32_16x16x32_bf16 v[68:71], v[112:115], v[36:39], 0
    s_waitcnt lgkmcnt(6)
    v_mfma_f32_16x16x32_bf16 v[68:71], v[116:119], v[40:43], v[68:71]
    s_waitcnt lgkmcnt(5)
    v_mfma_f32_16x16x32_bf16 v[68:71], v[120:123], v[44:47], v[68:71]
    s_waitcnt lgkmcnt(4)
    v_mfma_f32_16x16x32_bf16 v[68:71], v[124:127], v[48:51], v[68:71]
    s_waitcnt lgkmcnt(3)
    v_mfma_f32_16x16x32_bf16 v[72:75], v[128:131], v[36:39], 0
    s_waitcnt lgkmcnt(2)
    v_mfma_f32_16x16x32_bf16 v[72:75], v[132:135], v[40:43], v[72:75]
    s_waitcnt lgkmcnt(1)
    v_mfma_f32_16x16x32_bf16 v[72:75], v[136:139], v[44:47], v[72:75]
    s_waitcnt lgkmcnt(0)
    v_mfma_f32_16x16x32_bf16 v[72:75], v[140:143], v[48:51], v[72:75]
    s_cmp_lg_u32 s94, 0
    s_cbranch_scc1 L_skp_17
    v_mov_b32 v6, s78
    ds_write_b32 v3, v6 offset:8
L_skp_17:
    s_add_u32 s78, s78, 2
    s_nop 4
    v_max3_f32 v17, v68, v69, v70
    v_max3_f32 v17, v17, v71, v72
    v_max3_f32 v17, v17, v73, v74
    v_max_f32 v17, v17, v75
    v_mov_b32 v7, v17
    s_nop 1
    v_permlane32_swap_b32 v17, v7
    s_nop 1
    v_max_f32 v17, v17, v7
    v_mov_b32 v7, v17
    s_nop 1
    v_permlane16_swap_b32 v17, v7
    s_nop 1
    v_max_f32 v17, v17, v7
    v_mul_f32 v17, s84, v17
    v_max_f32 v17, v17, v14
    v_sub_f32 v16, v14, v17
    v_exp_f32 v16, v16
    v_mov_b32 v14, v17
    v_fma_f32 v176, v68, s84, -v17
    v_fma_f32 v177, v69, s84, -v17
    v_fma_f32 v178, v70, s84, -v17
    v_fma_f32 v179, v71, s84, -v17
    v_fma_f32 v180, v72, s84, -v17
    v_fma_f32 v181, v73, s84, -v17
    v_fma_f32 v182, v74, s84, -v17
    v_fma_f32 v183, v75, s84, -v17
    v_exp_f32 v176, v176
    v_exp_f32 v177, v177
    v_exp_f32 v178, v178
    v_exp_f32 v179, v179
    v_exp_f32 v180, v180
    v_exp_f32 v181, v181
    v_exp_f32 v182, v182
    v_exp_f32 v183, v183
    v_mul_f32 v15, v15, v16
    v_cvt_pk_bf16_f32 v76, v176, v177
    v_cvt_pk_bf16_f32 v77, v178, v179
    v_cvt_pk_bf16_f32 v78, v180, v181
    v_cvt_pk_bf16_f32 v79, v182, v183
    v_add_f32 v15, v15, v176
    v_add_f32 v15, v15, v177
    v_add_f32 v15, v15, v178
    v_add_f32 v15, v15, v179
    v_add_f32 v15, v15, v180
    v_add_f32 v15, v15, v181
    v_add_f32 v15, v15, v182
    v_add_f32 v15, v15, v183
    v_mul_f32 v80, v80, v16
    v_mul_f32 v81, v81, v16
    v_mul_f32 v82, v82, v16
    v_mul_f32 v83, v83, v16
    v_mul_f32 v84, v84, v16
    v_mul_f32 v85, v85, v16
    v_mul_f32 v86, v86, v16
    v_mul_f32 v87, v87, v16
    v_mul_f32 v88, v88, v16
    v_mul_f32 v89, v89, v16
    v_mul_f32 v90, v90, v16
    v_mul_f32 v91, v91, v16
    v_mul_f32 v92, v92, v16
    v_mul_f32 v93, v93, v16
    v_mul_f32 v94, v94, v16
    v_mul_f32 v95, v95, v16
    v_mul_f32 v96, v96, v16
    v_mul_f32 v97, v97, v16
    v_mul_f32 v98, v98, v16
    v_mul_f32 v99, v99, v16
    v_mul_f32 v100, v100, v16
    v_mul_f32 v101, v101, v16
    v_mul_f32 v102, v102, v16
    v_mul_f32 v103, v103, v16
    v_mul_f32 v104, v104, v16
    v_mul_f32 v105, v105, v16
    v_mul_f32 v106, v106, v16
    v_mul_f32 v107, v107, v16
    v_mul_f32 v108, v108, v16
    v_mul_f32 v109, v109, v16
    v_mul_f32 v110, v110, v16
    v_mul_f32 v111, v111, v16
    s_cmp_lg_u32 s94, 0
    s_cbranch_scc1 L_skp_18
    s_cmp_ge_i32 s81, s78
    s_cbranch_scc1 L_pfd_20
L_pf_19:
    ds_read_b64 v[4:5], v3
    s_waitcnt lgkmcnt(0)
    v_readfirstlane_b32 s81, v4
    v_readfirstlane_b32 s93, v5
    s_cmp_ge_i32 s81, s78
    s_cbranch_scc1 L_pfd_20
    s_cmp_eq_u32 s83, 0
    s_cbranch_scc1 L_pfd_20
    s_sub_u32 s83, s83, 1
    s_sleep 1
    s_branch L_pf_19
L_pfd_20:
    ds_read_b64_tr_b16 v[144:145], v24 offset:8192
    ds_read_b64_tr_b16 v[146:147], v24 offset:12288
    ds_read_b64_tr_b16 v[148:149], v25 offset:8192
    ds_read_b64_tr_b16 v[150:151], v25 offset:12288
    ds_read_b64_tr_b16 v[152:153], v26 offset:8192
    ds_read_b64_tr_b16 v[154:155], v26 offset:12288
    ds_read_b64_tr_b16 v[156:157], v27 offset:8192
    ds_read_b64_tr_b16 v[158:159], v27 offset:12288
    ds_read_b64_tr_b16 v[160:161], v28 offset:8192
    ds_read_b64_tr_b16 v[162:163], v28 offset:12288
    ds_read_b64_tr_b16 v[164:165], v29 offset:8192
    ds_read_b64_tr_b16 v[166:167], v29 offset:12288
    ds_read_b64_tr_b16 v[168:169], v30 offset:8192
    ds_read_b64_tr_b16 v[170:171], v30 offset:12288
    ds_read_b64_tr_b16 v[172:173], v31 offset:8192
    ds_read_b64_tr_b16 v[174:175], v31 offset:12288
L_skp_18:
    s_waitcnt lgkmcnt(14)
    v_mfma_f32_16x16x32_bf16 v[80:83], v[144:147], v[76:79], v[80:83]
    s_waitcnt lgkmcnt(12)
    v_mfma_f32_16x16x32_bf16 v[84:87], v[148:151], v[76:79], v[84:87]
    s_waitcnt lgkmcnt(10)
    v_mfma_f32_16x16x32_bf16 v[88:91], v[152:155], v[76:79], v[88:91]
    s_waitcnt lgkmcnt(8)
    v_mfma_f32_16x16x32_bf16 v[92:95], v[156:159], v[76:79], v[92:95]
    s_waitcnt lgkmcnt(6)
    v_mfma_f32_16x16x32_bf16 v[96:99], v[160:163], v[76:79], v[96:99]
    s_waitcnt lgkmcnt(4)
    v_mfma_f32_16x16x32_bf16 v[100:103], v[164:167], v[76:79], v[100:103]
    s_waitcnt lgkmcnt(2)
    v_mfma_f32_16x16x32_bf16 v[104:107], v[168:171], v[76:79], v[104:107]
    s_waitcnt lgkmcnt(0)
    v_mfma_f32_16x16x32_bf16 v[108:111], v[172:175], v[76:79], v[108:111]
    v_mov_b32 v6, s78
    ds_write_b32 v3, v6 offset:8
    s_add_u32 s78, s78, 2
    s_mov_b32 s94, 0
    s_cmp_ge_i32 s81, s78
    s_cbranch_scc1 L_pfd_22
    s_cmp_lt_i32 s93, s78
    s_cbranch_scc1 L_cexit
L_pf_21:
    ds_read_b64 v[4:5], v3
    s_waitcnt lgkmcnt(0)
    v_readfirstlane_b32 s81, v4
    v_readfirstlane_b32 s93, v5
    s_cmp_ge_i32 s81, s78
    s_cbranch_scc1 L_pfd_22
    s_cmp_lt_i32 s93, s78
    s_cbranch_scc1 L_cexit
    s_cmp_eq_u32 s83, 0
    s_cbranch_scc1 L_cexit
    s_sub_u32 s83, s83, 1
    s_sleep 1
    s_branch L_pf_21
L_pfd_22:
    ds_read_b128 v[112:115], v20 offset:16384
    ds_read_b128 v[116:119], v21 offset:16384
    ds_read_b128 v[120:123], v22 offset:16384
    ds_read_b128 v[124:127], v23 offset:16384
    ds_read_b128 v[128:131], v20 offset:20480
    ds_read_b128 v[132:135], v21 offset:20480
    ds_read_b128 v[136:139], v22 offset:20480
    ds_read_b128 v[140:143], v23 offset:20480
    s_waitcnt lgkmcnt(7)
    v_mfma_f32_16x16x32_bf16 v[68:71], v[112:115], v[36:39], 0
    s_waitcnt lgkmcnt(6)
    v_mfma_f32_16x16x32_bf16 v[68:71], v[116:119], v[40:43], v[68:71]
    s_waitcnt lgkmcnt(5)
    v_mfma_f32_16x16x32_bf16 v[68:71], v[120:123], v[44:47], v[68:71]
    s_waitcnt lgkmcnt(4)
    v_mfma_f32_16x16x32_bf16 v[68:71], v[124:127], v[48:51], v[68:71]
    s_waitcnt lgkmcnt(3)
    v_mfma_f32_16x16x32_bf16 v[72:75], v[128:131], v[36:39], 0
    s_waitcnt lgkmcnt(2)
    v_mfma_f32_16x16x32_bf16 v[72:75], v[132:135], v[40:43], v[72:75]
    s_waitcnt lgkmcnt(1)
    v_mfma_f32_16x16x32_bf16 v[72:75], v[136:139], v[44:47], v[72:75]
    s_waitcnt lgkmcnt(0)
    v_mfma_f32_16x16x32_bf16 v[72:75], v[140:143], v[48:51], v[72:75]
    v_mov_b32 v6, s78
    ds_write_b32 v3, v6 offset:8
    s_add_u32 s78, s78, 2
    s_nop 4
    v_max3_f32 v17, v68, v69, v70
    v_max3_f32 v17, v17, v71, v72
    v_max3_f32 v17, v17, v73, v74
    v_max_f32 v17, v17, v75
    v_mov_b32 v7, v17
    s_nop 1
    v_permlane32_swap_b32 v17, v7
    s_nop 1
    v_max_f32 v17, v17, v7
    v_mov_b32 v7, v17
    s_nop 1
    v_permlane16_swap_b32 v17, v7
    s_nop 1
    v_max_f32 v17, v17, v7
    v_mul_f32 v17, s84, v17
    v_max_f32 v17, v17, v14
    v_sub_f32 v16, v14, v17
    v_exp_f32 v16, v16
    v_mov_b32 v14, v17
    v_fma_f32 v176, v68, s84, -v17
    v_fma_f32 v177, v69, s84, -v17
    v_fma_f32 v178, v70, s84, -v17
    v_fma_f32 v179, v71, s84, -v17
    v_fma_f32 v180, v72, s84, -v17
    v_fma_f32 v181, v73, s84, -v17
    v_fma_f32 v182, v74, s84, -v17
    v_fma_f32 v183, v75, s84, -v17
    v_exp_f32 v176, v176
    v_exp_f32 v177, v177
    v_exp_f32 v178, v178
    v_exp_f32 v179, v179
    v_exp_f32 v180, v180
    v_exp_f32 v181, v181
    v_exp_f32 v182, v182
    v_exp_f32 v183, v183
    v_mul_f32 v15, v15, v16
    v_cvt_pk_bf16_f32 v76, v176, v177
    v_cvt_pk_bf16_f32 v77, v178, v179
    v_cvt_pk_bf16_f32 v78, v180, v181
    v_cvt_pk_bf16_f32 v79, v182, v183
    v_add_f32 v15, v15, v176
    v_add_f32 v15, v15, v177
    v_add_f32 v15, v15, v178
    v_add_f32 v15, v15, v179
    v_add_f32 v15, v15, v180
    v_add_f32 v15, v15, v181
    v_add_f32 v15, v15, v182
    v_add_f32 v15, v15, v183
    v_mul_f32 v80, v80, v16
    v_mul_f32 v81, v81, v16
    v_mul_f32 v82, v82, v16
    v_mul_f32 v83, v83, v16
    v_mul_f32 v84, v84, v16
    v_mul_f32 v85, v85, v16
    v_mul_f32 v86, v86, v16
    v_mul_f32 v87, v87, v16
    v_mul_f32 v88, v88, v16
    v_mul_f32 v89, v89, v16
    v_mul_f32 v90, v90, v16
    v_mul_f32 v91, v91, v16
    v_mul_f32 v92, v92, v16
    v_mul_f32 v93, v93, v16
    v_mul_f32 v94, v94, v16
    v_mul_f32 v95, v95, v16
    v_mul_f32 v96, v96, v16
    v_mul_f32 v97, v97, v16
    v_mul_f32 v98, v98, v16
    v_mul_f32 v99, v99, v16
    v_mul_f32 v100, v100, v16
    v_mul_f32 v101, v101, v16
    v_mul_f32 v102, v102, v16
    v_mul_f32 v103, v103, v16
    v_mul_f32 v104, v104, v16
    v_mul_f32 v105, v105, v16
    v_mul_f32 v106, v106, v16
    v_mul_f32 v107, v107, v16
    v_mul_f32 v108, v108, v16
    v_mul_f32 v109, v109, v16
    v_mul_f32 v110, v110, v16
    v_mul_f32 v111, v111, v16
    s_cmp_ge_i32 s81, s78
    s_cbranch_scc1 L_pfd_24
L_pf_23:
    ds_read_b64 v[4:5], v3
    s_waitcnt lgkmcnt(0)
    v_readfirstlane_b32 s81, v4
    v_readfirstlane_b32 s93, v5
    s_cmp_ge_i32 s81, s78
    s_cbranch_scc1 L_pfd_24
    s_cmp_eq_u32 s83, 0
    s_cbranch_scc1 L_pfd_24
    s_sub_u32 s83, s83, 1
    s_sleep 1
    s_branch L_pf_23
L_pfd_24:
    ds_read_b64_tr_b16 v[144:145], v24 offset:24576
    ds_read_b64_tr_b16 v[146:147], v24 offset:28672
    ds_read_b64_tr_b16 v[148:149], v25 offset:24576
    ds_read_b64_tr_b16 v[150:151], v25 offset:28672
    ds_read_b64_tr_b16 v[152:153], v26 offset:24576
    ds_read_b64_tr_b16 v[154:155], v26 offset:28672
    ds_read_b64_tr_b16 v[156:157], v27 offset:24576
    ds_read_b64_tr_b16 v[158:159], v27 offset:28672
    ds_read_b64_tr_b16 v[160:161], v28 offset:24576
    ds_read_b64_tr_b16 v[162:163], v28 offset:28672
    ds_read_b64_tr_b16 v[164:165], v29 offset:24576
    ds_read_b64_tr_b16 v[166:167], v29 offset:28672
    ds_read_b64_tr_b16 v[168:169], v30 offset:24576
    ds_read_b64_tr_b16 v[170:171], v30 offset:28672
    ds_read_b64_tr_b16 v[172:173], v31 offset:24576
    ds_read_b64_tr_b16 v[174:175], v31 offset:28672
    s_waitcnt lgkmcnt(14)
    v_mfma_f32_16x16x32_bf16 v[80:83], v[144:147], v[76:79], v[80:83]
    s_waitcnt lgkmcnt(12)
    v_mfma_f32_16x16x32_bf16 v[84:87], v[148:151], v[76:79], v[84:87]
    s_waitcnt lgkmcnt(10)
    v_mfma_f32_16x16x32_bf16 v[88:91], v[152:155], v[76:79], v[88:91]
    s_waitcnt lgkmcnt(8)
    v_mfma_f32_16x16x32_bf16 v[92:95], v[156:159], v[76:79], v[92:95]
    s_waitcnt lgkmcnt(6)
    v_mfma_f32_16x16x32_bf16 v[96:99], v[160:163], v[76:79], v[96:99]
    s_waitcnt lgkmcnt(4)
    v_mfma_f32_16x16x32_bf16 v[100:103], v[164:167], v[76:79], v[100:103]
    s_waitcnt lgkmcnt(2)
    v_mfma_f32_16x16x32_bf16 v[104:107], v[168:171], v[76:79], v[104:107]
    s_waitcnt lgkmcnt(0)
    v_mfma_f32_16x16x32_bf16 v[108:111], v[172:175], v[76:79], v[108:111]
    v_mov_b32 v6, s78
    ds_write_b32 v3, v6 offset:8
    s_add_u32 s78, s78, 2
    s_branch L_cloop
L_cexit:
    buffer_load_dwordx4 v[184:187], v229, s[64:67], 0 offen sc1
    s_nop 1
    s_mov_b32 exec_lo, 0x00ff00ff
    s_mov_b32 exec_hi, 0x00ff00ff
    ds_write_b128 v224, v[80:83] offset:0
    ds_write_b128 v224, v[84:87] offset:64
    ds_write_b128 v224, v[88:91] offset:128
    ds_write_b128 v224, v[92:95] offset:192
    ds_write_b128 v224, v[96:99] offset:256
    ds_write_b128 v224, v[100:103] offset:320
    ds_write_b128 v224, v[104:107] offset:384
    ds_write_b128 v224, v[108:111] offset:448
    s_mov_b64 exec, -1
    v_mov_b32 v6, v15
    s_nop 1
    v_permlane32_swap_b32 v15, v6
    s_nop 1
    v_add_f32 v15, v15, v6
    v_mov_b32 v6, v15
    s_nop 1
    v_permlane16_swap_b32 v15, v6
    s_nop 1
    v_add_f32 v15, v15, v6
    s_mov_b64 exec, 0xff
    ds_write_b64 v225, v[14:15]
    s_mov_b64 exec, -1
    v_mov_b32 v73, s90
    v_mov_b32 v75, s90
    s_waitcnt lgkmcnt(0)
    s_barrier
    ds_read_b64 v[176:177], v227 offset:0
    ds_read_b64 v[178:179], v227 offset:64
    ds_read_b64 v[180:181], v227 offset:128
    ds_read_b64 v[182:183], v227 offset:192
    ds_read_b128 v[112:115], v226 offset:0
    ds_read_b128 v[116:119], v226 offset:4224
    ds_read_b128 v[120:123], v226 offset:8448
    ds_read_b128 v[124:127], v226 offset:12672
    s_waitcnt lgkmcnt(4)
    v_max3_f32 v72, v176, v178, v180
    v_max_f32 v72, v72, v182
    v_sub_f32 v176, v176, v72
    v_sub_f32 v178, v178, v72
    v_sub_f32 v180, v180, v72
    v_sub_f32 v182, v182, v72
    v_exp_f32 v176, v176
    v_exp_f32 v178, v178
    v_exp_f32 v180, v180
    v_exp_f32 v182, v182
    s_waitcnt lgkmcnt(0)
    v_mul_f32 v68, v176, v112
    v_mul_f32 v69, v176, v113
    v_mul_f32 v70, v176, v114
    v_mul_f32 v71, v176, v115
    v_fmac_f32 v68, v178, v116
    v_fmac_f32 v69, v178, v117
    v_fmac_f32 v70, v178, v118
    v_fmac_f32 v71, v178, v119
    v_fmac_f32 v68, v180, v120
    v_fmac_f32 v69, v180, v121
    v_fmac_f32 v70, v180, v122
    v_fmac_f32 v71, v180, v123
    v_fmac_f32 v68, v182, v124
    v_fmac_f32 v69, v182, v125
    v_fmac_f32 v70, v182, v126
    v_fmac_f32 v71, v182, v127
    v_and_or_b32 v68, v68, s92, v18
    v_and_or_b32 v69, v69, s92, v18
    v_and_or_b32 v70, v70, s92, v18
    v_and_or_b32 v71, v71, s92, v18
    buffer_store_dwordx4 v[68:71], v10, s[64:67], 0 offen sc1
    v_mul_f32 v74, v176, v177
    v_fmac_f32 v74, v178, v179
    v_fmac_f32 v74, v180, v181
    v_fmac_f32 v74, v182, v183
    s_mov_b32 exec_lo, 1
    s_mov_b32 exec_hi, 1
    buffer_store_dwordx4 v[72:75], v11, s[64:67], 0 offen sc1
    s_mov_b64 exec, -1
    s_barrier
    s_waitcnt vmcnt(2)
    s_branch L_h1f_27
L_h1_25:
    s_waitcnt vmcnt(0)
    v_bitop3_b32 v6, v18, v52, v53 bitop3:0x7e
    v_bitop3_b32 v180, v18, v54, v55 bitop3:0x7e
    v_or_b32 v6, v6, v180
    v_and_b32 v6, 0x3ff, v6
    v_cmp_ne_u32 s[32:33], 0, v6
    v_bitop3_b32 v6, v18, v56, v57 bitop3:0x7e
    v_bitop3_b32 v180, v18, v58, v59 bitop3:0x7e
    v_or_b32 v6, v6, v180
    v_and_b32 v6, 0x3ff, v6
    v_cmp_ne_u32 s[34:35], 0, v6
    v_bitop3_b32 v6, v18, v60, v61 bitop3:0x7e
    v_bitop3_b32 v180, v18, v62, v63 bitop3:0x7e
    v_or_b32 v6, v6, v180
    v_and_b32 v6, 0x3ff, v6
    v_cmp_ne_u32 s[36:37], 0, v6
    v_bitop3_b32 v6, v18, v64, v65 bitop3:0x7e
    v_bitop3_b32 v180, v18, v66, v67 bitop3:0x7e
    v_or_b32 v6, v6, v180
    v_and_b32 v6, 0x3ff, v6
    v_cmp_ne_u32 s[38:39], 0, v6
L_h1f_27:
    v_bitop3_b32 v6, s90, v185, v187 bitop3:0x7e
    v_cmp_ne_u32 s[40:41], 0, v6
    s_or_b64 vcc, s[32:33], s[34:35]
    s_or_b64 vcc, vcc, s[36:37]
    s_or_b64 vcc, vcc, s[38:39]
    s_or_b64 vcc, vcc, s[40:41]
    s_cbranch_scc0 L_h1d_26
    s_cmp_eq_u32 s83, 0
    s_cbranch_scc1 L_h1d_26
    s_sub_u32 s83, s83, 1
    s_bcnt1_i32_b64 s82, s[40:41]
    s_cmp_le_u32 s82, 16
    s_cselect_b32 s87, -1, 0
    s_cbranch_scc1 L_h1ns_28
    s_sleep 2
L_h1ns_28:
    s_bitcmp0_b32 s40, 0
    s_cselect_b32 vcc_lo, -1, s87
    s_bitcmp0_b32 s41, 0
    s_cselect_b32 vcc_hi, -1, s87
    s_and_b64 exec, vcc, s[32:33]
    s_cbranch_execz L_h1s_29
    buffer_load_dwordx4 v[52:55], v228, s[64:67], 0 offen offset:0 sc1
L_h1s_29:
    s_bitcmp0_b32 s40, 1
    s_cselect_b32 vcc_lo, -1, s87
    s_bitcmp0_b32 s41, 1
    s_cselect_b32 vcc_hi, -1, s87
    s_and_b64 exec, vcc, s[34:35]
    s_cbranch_execz L_h1s_30
    buffer_load_dwordx4 v[56:59], v228, s[64:67], 0 offen offset:512 sc1
L_h1s_30:
    s_bitcmp0_b32 s40, 2
    s_cselect_b32 vcc_lo, -1, s87
    s_bitcmp0_b32 s41, 2
    s_cselect_b32 vcc_hi, -1, s87
    s_and_b64 exec, vcc, s[36:37]
    s_cbranch_execz L_h1s_31
    buffer_load_dwordx4 v[60:63], v228, s[64:67], 0 offen offset:1024 sc1
L_h1s_31:
    s_bitcmp0_b32 s40, 3
    s_cselect_b32 vcc_lo, -1, s87
    s_bitcmp0_b32 s41, 3
    s_cselect_b32 vcc_hi, -1, s87
    s_and_b64 exec, vcc, s[38:39]
    s_cbranch_execz L_h1s_32
    buffer_load_dwordx4 v[64:67], v228, s[64:67], 0 offen offset:1536 sc1
L_h1s_32:
    s_mov_b64 exec, s[40:41]
    s_cbranch_execz L_h1s_33
    buffer_load_dwordx4 v[184:187], v229, s[64:67], 0 offen sc1
L_h1s_33:
    s_mov_b64 exec, -1
    s_branch L_h1_25
L_h1d_26:
    v_mov_b32 v14, v184
    v_and_b32 v52, s92, v52
    v_and_b32 v53, s92, v53
    v_and_b32 v54, s92, v54
    v_and_b32 v55, s92, v55
    v_max_f32_dpp v14, v14, v14 row_ror:8 row_mask:0xf bank_mask:0xf
    v_and_b32 v56, s92, v56
    v_and_b32 v57, s92, v57
    v_and_b32 v58, s92, v58
    v_and_b32 v59, s92, v59
    v_max_f32_dpp v14, v14, v14 row_ror:4 row_mask:0xf bank_mask:0xf
    v_and_b32 v60, s92, v60
    v_and_b32 v61, s92, v61
    v_and_b32 v62, s92, v62
    v_and_b32 v63, s92, v63
    v_max_f32_dpp v14, v14, v14 row_ror:2 row_mask:0xf bank_mask:0xf
    v_and_b32 v64, s92, v64
    v_and_b32 v65, s92, v65
    v_and_b32 v66, s92, v66
    v_and_b32 v67, s92, v67
    v_max_f32_dpp v14, v14, v14 row_ror:1 row_mask:0xf bank_mask:0xf
    v_sub_f32 v16, v184, v14
    v_exp_f32 v16, v16
    v_mov_b32 v178, 1
    v_mul_f32 v15, v16, v186
    v_mul_f32_dpp v68, v16, v52 row_newbcast:0 row_mask:0xf bank_mask:0xf
    v_mul_f32_dpp v69, v16, v53 row_newbcast:0 row_mask:0xf bank_mask:0xf
    v_mul_f32_dpp v70, v16, v54 row_newbcast:0 row_mask:0xf bank_mask:0xf
    v_mul_f32_dpp v71, v16, v55 row_newbcast:0 row_mask:0xf bank_mask:0xf
    v_add_f32_dpp v15, v15, v15 row_ror:8 row_mask:0xf bank_mask:0xf
    v_fmac_f32_dpp v68, v16, v56 row_newbcast:1 row_mask:0xf bank_mask:0xf
    v_fmac_f32_dpp v69, v16, v57 row_newbcast:1 row_mask:0xf bank_mask:0xf
    v_fmac_f32_dpp v70, v16, v58 row_newbcast:1 row_mask:0xf bank_mask:0xf
    v_fmac_f32_dpp v71, v16, v59 row_newbcast:1 row_mask:0xf bank_mask:0xf
    v_add_f32_dpp v15, v15, v15 row_ror:4 row_mask:0xf bank_mask:0xf
    v_fmac_f32_dpp v68, v16, v60 row_newbcast:2 row_mask:0xf bank_mask:0xf
    v_fmac_f32_dpp v69, v16, v61 row_newbcast:2 row_mask:0xf bank_mask:0xf
    v_fmac_f32_dpp v70, v16, v62 row_newbcast:2 row_mask:0xf bank_mask:0xf
    v_fmac_f32_dpp v71, v16, v63 row_newbcast:2 row_mask:0xf bank_mask:0xf
    v_add_f32_dpp v15, v15, v15 row_ror:2 row_mask:0xf bank_mask:0xf
    v_fmac_f32_dpp v68, v16, v64 row_newbcast:3 row_mask:0xf bank_mask:0xf
    v_fmac_f32_dpp v69, v16, v65 row_newbcast:3 row_mask:0xf bank_mask:0xf
    v_fmac_f32_dpp v70, v16, v66 row_newbcast:3 row_mask:0xf bank_mask:0xf
    v_fmac_f32_dpp v71, v16, v67 row_newbcast:3 row_mask:0xf bank_mask:0xf
    v_add_f32_dpp v15, v15, v15 row_ror:1 row_mask:0xf bank_mask:0xf
    ds_write_b128 v230, v[68:71]
    v_rcp_f32 v15, v15
    s_waitcnt lgkmcnt(0)
    s_mov_b64 exec, 1
    ds_add_u32 v8, v178 offset:8
    s_mov_b64 exec, -1
    s_add_u32 s78, s78, 2
    ds_read_b32 v179, v3
    ds_read_b32 v180, v8 offset:8
    s_waitcnt lgkmcnt(0)
    v_readfirstlane_b32 s81, v179
    v_readfirstlane_b32 s82, v180
    s_mov_b32 s94, 0
    s_cmp_lt_i32 s81, s78
    s_cbranch_scc1 L_nl_36
    ds_read_b64_tr_b16 v[144:145], v32 offset:8192
    ds_read_b64_tr_b16 v[146:147], v32 offset:8704
    ds_read_b64_tr_b16 v[148:149], v33 offset:8192
    ds_read_b64_tr_b16 v[150:151], v33 offset:8704
    ds_read_b64_tr_b16 v[152:153], v34 offset:8192
    ds_read_b64_tr_b16 v[154:155], v34 offset:8704
    ds_read_b64_tr_b16 v[156:157], v35 offset:8192
    ds_read_b64_tr_b16 v[158:159], v35 offset:8704
    ds_read_b64_tr_b16 v[160:161], v32 offset:12288
    ds_read_b64_tr_b16 v[162:163], v32 offset:12800
    ds_read_b64_tr_b16 v[164:165], v33 offset:12288
    ds_read_b64_tr_b16 v[166:167], v33 offset:12800
    ds_read_b64_tr_b16 v[168:169], v34 offset:12288
    ds_read_b64_tr_b16 v[170:171], v34 offset:12800
    ds_read_b64_tr_b16 v[172:173], v35 offset:12288
    ds_read_b64_tr_b16 v[174:175], v35 offset:12800
    s_mov_b32 s94, 1
L_nl_36:
    s_cmp_ge_u32 s82, 4
    s_cbranch_scc1 L_xsd_35
L_xs_34:
    ds_read_b32 v180, v8 offset:8
    s_waitcnt lgkmcnt(0)
    v_readfirstlane_b32 s82, v180
    s_cmp_ge_u32 s82, 4
    s_cbranch_scc1 L_xsd_35
    s_cmp_eq_u32 s83, 0
    s_cbranch_scc1 L_xsd_35
    s_sub_u32 s83, s83, 1
    s_branch L_xs_34
L_xsd_35:
    ds_read_b128 v[36:39], v231 offset:0
    ds_read_b128 v[40:43], v231 offset:1024
    ds_read_b128 v[44:47], v231 offset:2048
    ds_read_b128 v[48:51], v231 offset:3072
    s_waitcnt lgkmcnt(0)
    v_add_f32 v36, v36, v40
    v_add_f32 v44, v44, v48
    v_add_f32 v37, v37, v41
    v_add_f32 v45, v45, v49
    v_add_f32 v38, v38, v42
    v_add_f32 v46, v46, v50
    v_add_f32 v39, v39, v43
    v_add_f32 v47, v47, v51
    v_add_f32 v36, v36, v44
    v_add_f32 v37, v37, v45
    v_add_f32 v38, v38, v46
    v_add_f32 v39, v39, v47
    v_mul_f32 v36, v36, v15
    v_mul_f32 v37, v37, v15
    v_mul_f32 v38, v38, v15
    v_mul_f32 v39, v39, v15
    v_cvt_pk_bf16_f32 v176, v36, v37
    v_cvt_pk_bf16_f32 v177, v38, v39
    ds_write_b64 v232, v[176:177]
    ds_read_b128 v[52:55], v233 offset:0
    ds_read_b128 v[56:59], v233 offset:64
    ds_read_b128 v[60:63], v233 offset:128
    ds_read_b128 v[64:67], v233 offset:192
    s_waitcnt lgkmcnt(3)
    v_mfma_f32_16x16x32_bf16 v[80:83], v[192:195], v[52:55], 0
    v_mfma_f32_16x16x32_bf16 v[84:87], v[196:199], v[52:55], 0
    v_mfma_f32_16x16x32_bf16 v[88:91], v[200:203], v[52:55], 0
    v_mfma_f32_16x16x32_bf16 v[92:95], v[204:207], v[52:55], 0
    s_waitcnt lgkmcnt(2)
    v_mfma_f32_16x16x32_bf16 v[80:83], v[208:211], v[56:59], v[80:83]
    v_mfma_f32_16x16x32_bf16 v[84:87], v[212:215], v[56:59], v[84:87]
    v_mfma_f32_16x16x32_bf16 v[88:91], v[216:219], v[56:59], v[88:91]
    v_mfma_f32_16x16x32_bf16 v[92:95], v[220:223], v[56:59], v[92:95]
    s_waitcnt lgkmcnt(0)
    s_cmp_lg_u32 s94, 0
    s_cbranch_scc1 L_lr_37
    s_cmp_ge_i32 s81, s78
    s_cbranch_scc1 L_pfd_39
L_pf_38:
    ds_read_b64 v[4:5], v3
    s_waitcnt lgkmcnt(0)
    v_readfirstlane_b32 s81, v4
    v_readfirstlane_b32 s93, v5
    s_cmp_ge_i32 s81, s78
    s_cbranch_scc1 L_pfd_39
    s_cmp_eq_u32 s83, 0
    s_cbranch_scc1 L_pfd_39
    s_sub_u32 s83, s83, 1
    s_branch L_pf_38
L_pfd_39:
    ds_read_b64_tr_b16 v[144:145], v32 offset:8192
    ds_read_b64_tr_b16 v[146:147], v32 offset:8704
    ds_read_b64_tr_b16 v[148:149], v33 offset:8192
    ds_read_b64_tr_b16 v[150:151], v33 offset:8704
    ds_read_b64_tr_b16 v[152:153], v34 offset:8192
    ds_read_b64_tr_b16 v[154:155], v34 offset:8704
    ds_read_b64_tr_b16 v[156:157], v35 offset:8192
    ds_read_b64_tr_b16 v[158:159], v35 offset:8704
    ds_read_b64_tr_b16 v[160:161], v32 offset:12288
    ds_read_b64_tr_b16 v[162:163], v32 offset:12800
    ds_read_b64_tr_b16 v[164:165], v33 offset:12288
    ds_read_b64_tr_b16 v[166:167], v33 offset:12800
    ds_read_b64_tr_b16 v[168:169], v34 offset:12288
    ds_read_b64_tr_b16 v[170:171], v34 offset:12800
    ds_read_b64_tr_b16 v[172:173], v35 offset:12288
    ds_read_b64_tr_b16 v[174:175], v35 offset:12800
    s_waitcnt lgkmcnt(0)
L_lr_37:
    v_mfma_f32_16x16x32_bf16 v[80:83], v[144:147], v[60:63], v[80:83]
    v_mfma_f32_16x16x32_bf16 v[84:87], v[148:151], v[60:63], v[84:87]
    v_mfma_f32_16x16x32_bf16 v[88:91], v[152:155], v[60:63], v[88:91]
    v_mfma_f32_16x16x32_bf16 v[92:95], v[156:159], v[60:63], v[92:95]
    v_mfma_f32_16x16x32_bf16 v[80:83], v[160:163], v[64:67], v[80:83]
    v_mfma_f32_16x16x32_bf16 v[84:87], v[164:167], v[64:67], v[84:87]
    v_mfma_f32_16x16x32_bf16 v[88:91], v[168:171], v[64:67], v[88:91]
    v_mfma_f32_16x16x32_bf16 v[92:95], v[172:175], v[64:67], v[92:95]
    s_mov_b32 exec_lo, 0x00030003
    s_mov_b32 exec_hi, 0x00030003
    s_nop 4
    v_and_or_b32 v80, v80, s92, v18
    v_and_or_b32 v81, v81, s92, v18
    v_and_or_b32 v82, v82, s92, v18
    v_and_or_b32 v83, v83, s92, v18
    buffer_store_dwordx4 v[80:83], v12, s[64:67], 0 offen offset:0 sc1
    v_and_or_b32 v84, v84, s92, v18
    v_and_or_b32 v85, v85, s92, v18
    v_and_or_b32 v86, v86, s92, v18
    v_and_or_b32 v87, v87, s92, v18
    buffer_store_dwordx4 v[84:87], v12, s[64:67], 0 offen offset:2048 sc1
    v_and_or_b32 v88, v88, s92, v18
    v_and_or_b32 v89, v89, s92, v18
    v_and_or_b32 v90, v90, s92, v18
    v_and_or_b32 v91, v91, s92, v18
    buffer_store_dwordx4 v[88:91], v13, s[64:67], 0 offen offset:0 sc1
    v_and_or_b32 v92, v92, s92, v18
    v_and_or_b32 v93, v93, s92, v18
    v_and_or_b32 v94, v94, s92, v18
    v_and_or_b32 v95, v95, s92, v18
    buffer_store_dwordx4 v[92:95], v13, s[64:67], 0 offen offset:2048 sc1
    s_mov_b64 exec, -1
    s_cmp_lg_u32 s76, 0
    s_cbranch_scc1 L_cdone
    s_mov_b64 vcc, -1
L_h2_40:
    s_or_b64 exec, vcc, 1
    buffer_load_dwordx4 v[120:123], v234, s[64:67], 0 offen sc1
    buffer_load_dwordx4 v[124:127], v234, s[64:67], 0 offen offset:1024 sc1
    s_mov_b64 exec, -1
    s_waitcnt vmcnt(0)
    v_bitop3_b32 v6, v18, v120, v121 bitop3:0x7e
    v_bitop3_b32 v176, v18, v122, v123 bitop3:0x7e
    v_bitop3_b32 v177, v18, v124, v125 bitop3:0x7e
    v_or3_b32 v6, v6, v176, v177
    v_bitop3_b32 v176, v18, v126, v127 bitop3:0x7e
    v_or_b32 v6, v6, v176
    v_and_b32 v6, 0x3ff, v6
    v_cmp_ne_u32 vcc, 0, v6
    s_cbranch_vccz L_h2d_41
    s_cmp_eq_u32 s83, 0
    s_cbranch_scc1 L_h2d_41
    s_sub_u32 s83, s83, 1
    s_branch L_h2_40
L_h2d_41:
    v_and_b32 v112, s92, v120
    v_and_b32 v113, s92, v121
    v_and_b32 v114, s92, v122
    v_and_b32 v115, s92, v123
    v_and_b32 v116, s92, v124
    v_and_b32 v117, s92, v125
    v_and_b32 v118, s92, v126
    v_and_b32 v119, s92, v127
    v_add_f32 v112, v112, v116
    v_add_f32 v113, v113, v117
    v_add_f32 v114, v114, v118
    v_add_f32 v115, v115, v119
    v_add_f32_dpp v112, v112, v112 row_ror:8 row_mask:0xf bank_mask:0xf
    v_add_f32_dpp v113, v113, v113 row_ror:8 row_mask:0xf bank_mask:0xf
    v_add_f32_dpp v114, v114, v114 row_ror:8 row_mask:0xf bank_mask:0xf
    v_add_f32_dpp v115, v115, v115 row_ror:8 row_mask:0xf bank_mask:0xf
    v_add_f32_dpp v112, v112, v112 row_ror:4 row_mask:0xf bank_mask:0xf
    v_add_f32_dpp v113, v113, v113 row_ror:4 row_mask:0xf bank_mask:0xf
    v_add_f32_dpp v114, v114, v114 row_ror:4 row_mask:0xf bank_mask:0xf
    v_add_f32_dpp v115, v115, v115 row_ror:4 row_mask:0xf bank_mask:0xf
    v_add_f32_dpp v112, v112, v112 row_ror:2 row_mask:0xf bank_mask:0xf
    v_add_f32_dpp v113, v113, v113 row_ror:2 row_mask:0xf bank_mask:0xf
    v_add_f32_dpp v114, v114, v114 row_ror:2 row_mask:0xf bank_mask:0xf
    v_add_f32_dpp v115, v115, v115 row_ror:2 row_mask:0xf bank_mask:0xf
    v_add_f32_dpp v112, v112, v112 row_ror:1 row_mask:0xf bank_mask:0xf
    v_add_f32_dpp v113, v113, v113 row_ror:1 row_mask:0xf bank_mask:0xf
    v_add_f32_dpp v114, v114, v114 row_ror:1 row_mask:0xf bank_mask:0xf
    v_add_f32_dpp v115, v115, v115 row_ror:1 row_mask:0xf bank_mask:0xf
    v_cvt_pk_bf16_f32 v176, v112, v113
    v_cvt_pk_bf16_f32 v177, v114, v115
    s_mov_b32 exec_lo, 0x00010001
    s_mov_b32 exec_hi, 0x00010001
    buffer_store_dwordx2 v[176:177], v235, s[72:75], 0 offen
    s_cmp_lg_u32 s11, 0
    s_cbranch_scc1 L_cdone
    s_mov_b64 exec, 1
    s_lshl_b32 s82, s6, 7
    v_mov_b32 v4, s82
    v_mov_b32 v6, s90
    buffer_store_dword v6, v4, s[64:67], 0 offen
L_cdone:
    s_mov_b64 exec, -1
    s_endpgm
.section .rodata,"a"
.p2align 6
.amdhsa_kernel concat_heads__gqa_block_cached__gqa_block_cached__decode_kernel
  .amdhsa_next_free_vgpr 240
  .amdhsa_next_free_sgpr 102
  .amdhsa_accum_offset 240
  .amdhsa_group_segment_fixed_size 0
  .amdhsa_kernarg_size 104
  .amdhsa_user_sgpr_count 2
  .amdhsa_user_sgpr_kernarg_segment_ptr 1
  .amdhsa_system_sgpr_workgroup_id_x 1
.end_amdhsa_kernel
```
